```python
import torch

def _softmax(x, axis=-1):
    return torch.softmax(x, dim=axis)
def _gelu(x):
    return torch.nn.functional.gelu(x, approximate="tanh")
def _silu(x):
    return torch.nn.functional.silu(x)
def _sigmoid(x):
    return torch.sigmoid(x)
def _layernorm(x, axis=-1, eps=1e-5):
    m = x.mean(dim=axis, keepdim=True)
    v = x.var(dim=axis, keepdim=True, unbiased=False)
    return (x - m) / torch.sqrt(v + eps)
def _scatter_add(tgt, idx, src, axis=0):
    return tgt.clone().index_add_(axis, idx, src)
def _segment_sum(src, seg, n):
    out = torch.zeros((n,) + src.shape[1:], dtype=src.dtype)
    return out.index_add_(0, seg, src)
def _pad(x, pw):
    flat = tuple(v for pair in reversed(pw) for v in pair)
    return torch.nn.functional.pad(x, flat)

kernel_name = 'parallel_sum__sliding_block_cached__dense_activation_silu__decode'

def setup_inputs():

    _w = (lambda a: (lambda t: t.to(torch.bfloat16) if t.is_floating_point() else t)(torch.as_tensor(a)))
    def _A_setup():
        B, Sq, D = 1, 1, 512
        Hq, Hkv, Sk, Dh = 32, 8, 65536, 128
        assert Hq % Hkv == 0, (Hq, Hkv)
        return {
            "x": _w((lambda *s: torch.randn(*s, dtype=torch.bfloat16) * 0.05)(B, Sq, D)),
            "k_cache": _w((lambda *s: torch.randn(*s, dtype=torch.bfloat16) * 3.2)(B, Hkv, Sk, Dh)),
            "v_cache": _w((lambda *s: torch.randn(*s, dtype=torch.bfloat16) * 0.8)(B, Hkv, Sk, Dh)),
            "wq": _w((lambda *s: torch.randn(*s, dtype=torch.bfloat16) * 3.2)(D, Hq * Dh) * (D ** -0.5)),
            "wo": _w((lambda *s: torch.randn(*s, dtype=torch.bfloat16) * 0.8)(Hq * Dh, D) * ((Hq * Dh) ** -0.5)),
        }
    _A_in = _A_setup()

    def _B_setup():
        B, S, D, F = 1, 1, 512, 1792
        return {
            "x": _w((lambda *s: torch.randn(*s, dtype=torch.bfloat16) * 0.05)(B, S, D)),
            "w1": _w((lambda *s: torch.randn(*s, dtype=torch.bfloat16) * 3.2)(D, F) * (D ** -0.5)),
            "w2": _w((lambda *s: torch.randn(*s, dtype=torch.bfloat16) * 0.4)(F, D) * (F ** -0.5)),
        }
    _B_in = _B_setup()

    return {
        "A_x": _A_in["x"],
        "A_k_cache": _A_in["k_cache"],
        "A_v_cache": _A_in["v_cache"],
        "A_wq": _A_in["wq"],
        "A_wo": _A_in["wo"],
        "B_x": _B_in["x"],
        "B_w1": _B_in["w1"],
        "B_w2": _B_in["w2"],
    }

def reference(A_x, A_k_cache, A_v_cache, A_wq, A_wo, B_x, B_w1, B_w2):
    def _A_ref(x, k_cache, v_cache, wq, wo):
        B, Sq, D = x.shape
        Hq, Dh = 32, 128
        Hkv, Sk = k_cache.shape[1], k_cache.shape[2]
        W = min(4096, max(256, Sk // 4))
        rep = Hq // Hkv
        q = (lambda x, *d: x.permute(*d))((x @ wq).reshape(B, Sq, Hq, Dh), 0, 2, 1, 3)
        k = (lambda x, n, axis: torch.repeat_interleave(x, n, dim=axis))(k_cache[:, :, Sk - W:, :], rep, axis=1)
        v = (lambda x, n, axis: torch.repeat_interleave(x, n, dim=axis))(v_cache[:, :, Sk - W:, :], rep, axis=1)
        scores = torch.einsum("bhqd,bhkd->bhqk", q, k) * (Dh ** -0.5)
        p = _softmax(scores, axis=-1)
        o = torch.einsum("bhqk,bhkd->bhqd", p, v)
        return (lambda x, *d: x.permute(*d))(o, 0, 2, 1, 3).reshape(B, Sq, Hq * Dh) @ wo

    def _B_ref(x, w1, w2):
        h = torch.einsum("bsd,df->bsf", x, w1)
        h = _silu(h)
        out = torch.einsum("bsf,fd->bsd", h, w2)
        return out

    x = A_x
    xn = _layernorm(x, axis=-1)
    return x + _A_ref(xn, A_k_cache, A_v_cache, A_wq, A_wo) + _B_ref(xn, B_w1, B_w2)
```

```asm
; @launch grid=(256,1,1) block=(512,1,1) lds=16384
.amdgcn_target "amdgcn-amd-amdhsa--gfx950"
.text
.globl parallel_sum__sliding_block_cached__dense_activation_silu__decode_kernel
.p2align 8
.type parallel_sum__sliding_block_cached__dense_activation_silu__decode_kernel,@function
parallel_sum__sliding_block_cached__dense_activation_silu__decode_kernel:
    s_load_dwordx16 s[4:19], s[0:1], 0
    s_load_dwordx4 s[20:23], s[0:1], 64
    s_load_dwordx2 s[24:25], s[0:1], 80
    v_lshrrev_b32 v2, 6, v0
    s_cmp_ge_u32 s2, 256
    v_readfirstlane_b32 s28, v2
    s_cbranch_scc1 L_end
    v_and_b32 v1, 63, v0
    s_and_b32 s26, s2, 7
    s_lshr_b32 s27, s2, 3
    v_lshrrev_b32 v125, 4, v1
    v_and_b32 v126, 7, v1
    v_lshrrev_b32 v124, 3, v1
    v_lshlrev_b32 v2, 4, v1
    s_cmp_ge_u32 s28, 4
    s_cbranch_scc1 L_att_setup
    s_mov_b32 s39, s27
    s_mov_b32 s3, s26
    s_xor_b32 s57, s27, 16
    s_cmp_lt_u32 s39, 28
    s_cselect_b32 s30, 2, 1
    s_cmp_ge_u32 s28, s30
    s_cbranch_scc1 L_idle
    s_lshl_b32 s31, s26, 3
    s_lshr_b32 s32, s57, 2
    s_add_u32 s31, s31, s32
    s_and_b32 s30, s27, 3
    s_cmp_eq_u32 s28, 0
    s_cselect_b32 s62, s31, s39
    s_cselect_b32 s63, s30, s3
    s_movk_i32 s32, 3584
    s_cselect_b32 s32, 0x2000, s32
    s_cselect_b32 s61, 2, 3
    v_lshlrev_b32 v3, s61, v124
    v_add_u32 v3, s63, v3
    s_lshl_b32 s30, s32, 3
    v_mul_u32_u24 v3, s30, v3
    s_lshl_b32 s31, s62, 7
    v_lshl_add_u32 v4, v126, 4, s31
    v_add_u32 v3, v4, v3
    s_cmp_eq_u32 s28, 0
    s_waitcnt lgkmcnt(0)
    s_cselect_b64 s[58:59], s[10:11], s[16:17]
    global_load_dwordx4 v[100:103], v2, s[4:5]
L_ld:
    global_load_dwordx4 v[4:7], v3, s[58:59] nt
    v_add_u32 v3, s32, v3
    global_load_dwordx4 v[8:11], v3, s[58:59] nt
    v_add_u32 v3, s32, v3
    global_load_dwordx4 v[12:15], v3, s[58:59] nt
    v_add_u32 v3, s32, v3
    s_cmp_ge_u32 s28, 4
    s_cbranch_scc1 L_att_k
    global_load_dwordx4 v[16:19], v3, s[58:59] nt
    v_add_u32 v3, s32, v3
    global_load_dwordx4 v[20:23], v3, s[58:59] nt
    v_add_u32 v3, s32, v3
    global_load_dwordx4 v[24:27], v3, s[58:59] nt
    v_add_u32 v3, s32, v3
    global_load_dwordx4 v[28:31], v3, s[58:59] nt
    v_add_u32 v3, s32, v3
    global_load_dwordx4 v[32:35], v3, s[58:59] nt
    s_load_dword s29, s[24:25], 0x0
    s_cmp_lg_u32 s28, 0
    s_cbranch_scc1 L_ld_done
    v_add_u32 v3, 0x1f2000, v3
    global_load_dwordx4 v[36:39], v3, s[58:59] nt
    v_add_u32 v3, s32, v3
    global_load_dwordx4 v[40:43], v3, s[58:59] nt
    v_add_u32 v3, s32, v3
    global_load_dwordx4 v[44:47], v3, s[58:59] nt
    v_add_u32 v3, s32, v3
    global_load_dwordx4 v[48:51], v3, s[58:59] nt
    v_add_u32 v3, s32, v3
    global_load_dwordx4 v[52:55], v3, s[58:59] nt
    v_add_u32 v3, s32, v3
    global_load_dwordx4 v[56:59], v3, s[58:59] nt
    v_add_u32 v3, s32, v3
    global_load_dwordx4 v[60:63], v3, s[58:59] nt
    v_add_u32 v3, s32, v3
    global_load_dwordx4 v[64:67], v3, s[58:59] nt
    s_barrier
    s_waitcnt vmcnt(16)
    s_branch L_ln
L_att_setup:
    s_sub_u32 s36, s28, 4
    s_lshl_b32 s30, s26, 24
    s_lshr_b32 s31, s27, 2
    s_lshl_b32 s31, s31, 4
    s_and_b32 s32, s27, 3
    s_add_u32 s31, s31, s32
    s_lshl_b32 s32, s36, 2
    s_add_u32 s31, s31, s32
    s_and_b32 s32, s31, 63
    s_lshl_b32 s32, s32, 10
    s_add_u32 s30, s30, s32
    s_lshr_b32 s31, s31, 6
    s_lshl_b32 s31, s31, 19
    s_add_u32 s30, s30, s31
    s_add_u32 s30, s30, 0xf00000
    v_bfe_u32 v123, v1, 2, 2
    v_and_b32 v122, 3, v1
    v_lshlrev_b32 v127, 8, v123
    v_lshl_add_u32 v127, v125, 6, v127
    v_lshl_add_u32 v127, v122, 4, v127
    v_add_u32 v3, s30, v127
    s_mov_b32 s32, 65536
    s_waitcnt lgkmcnt(0)
    s_mov_b64 s[58:59], s[6:7]
    s_barrier
    s_branch L_ld
L_idle:
    s_getpc_b64 s[60:61]
L_pc:
    s_and_b32 s60, s60, 0xffffff00
    s_and_b32 s30, s27, 3
    s_lshl_b32 s30, s30, 1
    s_and_b32 s31, s28, 1
    s_add_u32 s30, s30, s31
    s_min_u32 s30, s30, 5
    s_lshl_b32 s30, s30, 10
    v_add_u32 v3, s30, v2
    global_load_dwordx4 v[104:107], v3, s[60:61]
    s_lshl_b32 s30, s26, 14
    s_lshl_b32 s31, s57, 9
    s_add_u32 s30, s30, s31
    s_add_u32 s30, s30, 0x20000
    v_and_b32 v3, 0x1f0, v2
    v_add_u32 v3, s30, v3
    s_waitcnt lgkmcnt(0)
    global_load_dwordx4 v[108:111], v3, s[24:25] sc1
    s_load_dword s29, s[24:25], 0x0
    s_barrier
    s_waitcnt lgkmcnt(0)
    s_add_u32 s29, s29, 1
    s_branch L_w_common
L_ld_done:
    s_cmp_ge_u32 s28, 4
    s_cbranch_scc1 L_att
    s_barrier
    s_waitcnt vmcnt(8)
L_ln:
    v_lshlrev_b32 v104, 16, v100
    v_and_b32 v105, 0xffff0000, v100
    v_lshlrev_b32 v106, 16, v101
    v_and_b32 v107, 0xffff0000, v101
    v_lshlrev_b32 v108, 16, v102
    v_and_b32 v109, 0xffff0000, v102
    v_lshlrev_b32 v110, 16, v103
    v_and_b32 v111, 0xffff0000, v103
    v_add_f32 v120, v104, v105
    v_add_f32 v121, v106, v107
    v_add_f32 v122, v108, v109
    v_add_f32 v123, v110, v111
    v_add_f32 v120, v120, v121
    v_add_f32 v122, v122, v123
    v_add_f32 v120, v120, v122
    s_mov_b32 s37, 0x05040100
    s_mov_b32 s38, 0x07060302
    v_add_f32_dpp v120, v120, v120 row_ror:8 row_mask:0xf bank_mask:0xf
    s_nop 1
    v_add_f32_dpp v120, v120, v120 row_ror:4 row_mask:0xf bank_mask:0xf
    s_nop 1
    v_add_f32_dpp v120, v120, v120 row_ror:2 row_mask:0xf bank_mask:0xf
    s_nop 1
    v_add_f32_dpp v120, v120, v120 row_ror:1 row_mask:0xf bank_mask:0xf
    v_mov_b32 v121, v120
    s_nop 1
    v_permlane16_swap_b32 v120, v121
    v_add_f32 v120, v120, v121
    v_mov_b32 v121, v120
    s_nop 1
    v_permlane32_swap_b32 v120, v121
    v_add_f32 v120, v120, v121
    v_mul_f32 v120, 0x3b000000, v120
    v_sub_f32 v112, v104, v120
    v_sub_f32 v113, v105, v120
    v_sub_f32 v114, v106, v120
    v_sub_f32 v115, v107, v120
    v_sub_f32 v116, v108, v120
    v_sub_f32 v117, v109, v120
    v_sub_f32 v118, v110, v120
    v_sub_f32 v119, v111, v120
    v_mul_f32 v121, v112, v112
    v_mul_f32 v122, v113, v113
    v_fmac_f32 v121, v114, v114
    v_fmac_f32 v122, v115, v115
    v_fmac_f32 v121, v116, v116
    v_fmac_f32 v122, v117, v117
    v_fmac_f32 v121, v118, v118
    v_fmac_f32 v122, v119, v119
    v_add_f32 v121, v121, v122
    v_cvt_pk_bf16_f32 v120, v120, v120
    v_and_b32 v120, 0xffff0000, v120
    v_add_f32_dpp v121, v121, v121 row_ror:8 row_mask:0xf bank_mask:0xf
    s_nop 1
    v_add_f32_dpp v121, v121, v121 row_ror:4 row_mask:0xf bank_mask:0xf
    s_nop 1
    v_add_f32_dpp v121, v121, v121 row_ror:2 row_mask:0xf bank_mask:0xf
    s_nop 1
    v_add_f32_dpp v121, v121, v121 row_ror:1 row_mask:0xf bank_mask:0xf
    v_mov_b32 v122, v121
    s_nop 1
    v_permlane16_swap_b32 v121, v122
    v_add_f32 v121, v121, v122
    v_mov_b32 v122, v121
    s_nop 1
    v_permlane32_swap_b32 v121, v122
    v_add_f32 v121, v121, v122
    v_sub_f32 v104, v104, v120
    v_sub_f32 v105, v105, v120
    v_sub_f32 v106, v106, v120
    v_sub_f32 v107, v107, v120
    v_sub_f32 v108, v108, v120
    v_sub_f32 v109, v109, v120
    v_sub_f32 v110, v110, v120
    v_sub_f32 v111, v111, v120
    v_mul_f32 v121, 0x3b000000, v121
    v_cvt_pk_bf16_f32 v121, v121, v121
    v_and_b32 v121, 0xffff0000, v121
    v_add_f32 v121, 0x3727c5ac, v121
    v_cvt_pk_bf16_f32 v121, v121, v121
    v_and_b32 v121, 0xffff0000, v121
    v_sqrt_f32 v121, v121
    v_cvt_pk_bf16_f32 v100, v104, v105
    v_cvt_pk_bf16_f32 v101, v106, v107
    v_cvt_pk_bf16_f32 v102, v108, v109
    v_cvt_pk_bf16_f32 v103, v110, v111
    v_cvt_pk_bf16_f32 v121, v121, v121
    v_and_b32 v121, 0xffff0000, v121
    v_rcp_f32 v121, v121
    v_lshlrev_b32 v104, 16, v100
    v_and_b32 v105, 0xffff0000, v100
    v_lshlrev_b32 v106, 16, v101
    v_and_b32 v107, 0xffff0000, v101
    v_lshlrev_b32 v108, 16, v102
    v_and_b32 v109, 0xffff0000, v102
    v_lshlrev_b32 v110, 16, v103
    v_and_b32 v111, 0xffff0000, v103
    v_mul_f32 v104, v104, v121
    v_mul_f32 v105, v105, v121
    v_mul_f32 v106, v106, v121
    v_mul_f32 v107, v107, v121
    v_mul_f32 v108, v108, v121
    v_mul_f32 v109, v109, v121
    v_mul_f32 v110, v110, v121
    v_mul_f32 v111, v111, v121
    v_cvt_pk_bf16_f32 v100, v104, v105
    v_cvt_pk_bf16_f32 v101, v106, v107
    v_cvt_pk_bf16_f32 v102, v108, v109
    v_cvt_pk_bf16_f32 v103, v110, v111
    ds_write_b128 v2, v[100:103] offset:0
    s_lshl_b32 s30, s63, 4
    v_and_b32 v127, 1, v1
    v_lshl_add_u32 v127, v125, 1, v127
    v_lshlrev_b32 v127, s61, v127
    v_lshl_add_u32 v127, v127, 4, s30
    s_getreg_b32 s34, hwreg(HW_REG_XCC_ID)
    s_lshl_b32 s30, s62, s61
    s_add_u32 s30, s30, s63
    s_lshl_b32 s30, s30, 9
    s_lshl_b32 s31, s28, 17
    s_add_u32 s30, s30, s31
    s_add_u32 s30, s30, 0x20000
    v_lshlrev_b32 v3, 4, v126
    v_lshl_add_u32 v3, v125, 7, v3
    v_add_u32 v3, s30, v3
    s_waitcnt lgkmcnt(0)
    ds_read_b128 v[104:107], v127 offset:0
    ds_read_b128 v[108:111], v127 offset:512
    s_add_u32 s29, s29, 1
    v_mov_b32 v122, s34
    v_mov_b32 v123, s29
    s_cmp_eq_u32 s28, 0
    s_cbranch_scc1 L_q0
    s_waitcnt vmcnt(0)
L_q0:
    s_waitcnt vmcnt(14)
    v_perm_b32 v68, v8, v4, s37
    v_perm_b32 v72, v8, v4, s38
    v_perm_b32 v76, v9, v5, s37
    v_perm_b32 v80, v9, v5, s38
    v_perm_b32 v84, v10, v6, s37
    v_perm_b32 v88, v10, v6, s38
    v_perm_b32 v92, v11, v7, s37
    v_perm_b32 v96, v11, v7, s38
    s_waitcnt vmcnt(12)
    v_perm_b32 v69, v16, v12, s37
    v_perm_b32 v73, v16, v12, s38
    v_perm_b32 v77, v17, v13, s37
    v_perm_b32 v81, v17, v13, s38
    v_perm_b32 v85, v18, v14, s37
    v_perm_b32 v89, v18, v14, s38
    v_perm_b32 v93, v19, v15, s37
    v_perm_b32 v97, v19, v15, s38
    s_waitcnt vmcnt(10)
    v_perm_b32 v70, v24, v20, s37
    v_perm_b32 v74, v24, v20, s38
    v_perm_b32 v78, v25, v21, s37
    v_perm_b32 v82, v25, v21, s38
    v_perm_b32 v86, v26, v22, s37
    v_perm_b32 v90, v26, v22, s38
    v_perm_b32 v94, v27, v23, s37
    v_perm_b32 v98, v27, v23, s38
    s_waitcnt vmcnt(8)
    v_perm_b32 v71, v32, v28, s37
    v_perm_b32 v75, v32, v28, s38
    v_perm_b32 v79, v33, v29, s37
    v_perm_b32 v83, v33, v29, s38
    v_perm_b32 v87, v34, v30, s37
    v_perm_b32 v91, v34, v30, s38
    v_perm_b32 v95, v35, v31, s37
    v_perm_b32 v99, v35, v31, s38
    s_waitcnt lgkmcnt(0)
    v_mfma_f32_16x16x32_bf16 v[4:7], v[104:107], v[68:71], 0
    v_mfma_f32_16x16x32_bf16 v[8:11], v[104:107], v[72:75], 0
    v_mfma_f32_16x16x32_bf16 v[12:15], v[104:107], v[76:79], 0
    v_mfma_f32_16x16x32_bf16 v[16:19], v[104:107], v[80:83], 0
    v_mfma_f32_16x16x32_bf16 v[20:23], v[104:107], v[84:87], 0
    v_mfma_f32_16x16x32_bf16 v[24:27], v[104:107], v[88:91], 0
    v_mfma_f32_16x16x32_bf16 v[28:31], v[104:107], v[92:95], 0
    v_mfma_f32_16x16x32_bf16 v[32:35], v[104:107], v[96:99], 0
    s_cbranch_scc0 L_pub
    s_waitcnt vmcnt(6)
    v_perm_b32 v68, v40, v36, s37
    v_perm_b32 v72, v40, v36, s38
    v_perm_b32 v76, v41, v37, s37
    v_perm_b32 v80, v41, v37, s38
    v_perm_b32 v84, v42, v38, s37
    v_perm_b32 v88, v42, v38, s38
    v_perm_b32 v92, v43, v39, s37
    v_perm_b32 v96, v43, v39, s38
    s_waitcnt vmcnt(4)
    v_perm_b32 v69, v48, v44, s37
    v_perm_b32 v73, v48, v44, s38
    v_perm_b32 v77, v49, v45, s37
    v_perm_b32 v81, v49, v45, s38
    v_perm_b32 v85, v50, v46, s37
    v_perm_b32 v89, v50, v46, s38
    v_perm_b32 v93, v51, v47, s37
    v_perm_b32 v97, v51, v47, s38
    s_waitcnt vmcnt(2)
    v_perm_b32 v70, v56, v52, s37
    v_perm_b32 v74, v56, v52, s38
    v_perm_b32 v78, v57, v53, s37
    v_perm_b32 v82, v57, v53, s38
    v_perm_b32 v86, v58, v54, s37
    v_perm_b32 v90, v58, v54, s38
    v_perm_b32 v94, v59, v55, s37
    v_perm_b32 v98, v59, v55, s38
    s_waitcnt vmcnt(0)
    v_perm_b32 v71, v64, v60, s37
    v_perm_b32 v75, v64, v60, s38
    v_perm_b32 v79, v65, v61, s37
    v_perm_b32 v83, v65, v61, s38
    v_perm_b32 v87, v66, v62, s37
    v_perm_b32 v91, v66, v62, s38
    v_perm_b32 v95, v67, v63, s37
    v_perm_b32 v99, v67, v63, s38
    v_mfma_f32_16x16x32_bf16 v[4:7], v[108:111], v[68:71], v[4:7]
    v_mfma_f32_16x16x32_bf16 v[8:11], v[108:111], v[72:75], v[8:11]
    v_mfma_f32_16x16x32_bf16 v[12:15], v[108:111], v[76:79], v[12:15]
    v_mfma_f32_16x16x32_bf16 v[16:19], v[108:111], v[80:83], v[16:19]
    v_mfma_f32_16x16x32_bf16 v[20:23], v[108:111], v[84:87], v[20:23]
    v_mfma_f32_16x16x32_bf16 v[24:27], v[108:111], v[88:91], v[24:27]
    v_mfma_f32_16x16x32_bf16 v[28:31], v[108:111], v[92:95], v[28:31]
    v_mfma_f32_16x16x32_bf16 v[32:35], v[108:111], v[96:99], v[32:35]
L_pub:
    s_nop 0
    v_add_f32_dpp v120, v5, v4 row_ror:8 row_mask:0x1 bank_mask:0xf
    v_add_f32_dpp v121, v9, v8 row_ror:8 row_mask:0x1 bank_mask:0xf
    s_nop 0
    v_add_f32_dpp v120, v13, v12 row_ror:8 row_mask:0x2 bank_mask:0xf
    v_add_f32_dpp v121, v17, v16 row_ror:8 row_mask:0x2 bank_mask:0xf
    s_nop 0
    v_add_f32_dpp v120, v21, v20 row_ror:8 row_mask:0x4 bank_mask:0xf
    v_add_f32_dpp v121, v25, v24 row_ror:8 row_mask:0x4 bank_mask:0xf
    s_nop 0
    v_add_f32_dpp v120, v29, v28 row_ror:8 row_mask:0x8 bank_mask:0xf
    v_add_f32_dpp v121, v33, v32 row_ror:8 row_mask:0x8 bank_mask:0xf
    s_mov_b32 exec_lo, 0x00ff00ff
    s_mov_b32 exec_hi, 0x00ff00ff
    s_cbranch_scc0 L_pub2
    global_store_dwordx4 v3, v[120:123], s[24:25]
    s_nop 1
    v_xor_b32 v3, 0x80000, v3
L_pub2:
    global_store_dwordx4 v3, v[120:123], s[24:25] sc1
    s_mov_b64 exec, -1
L_w_common:
    s_lshl_b32 s30, s26, 9
    s_and_b32 s32, s27, 24
    s_lshl_b32 s31, s32, 4
    s_add_u32 s30, s30, s31
    s_and_b32 s36, s27, 7
    s_add_u32 s30, s30, s36
    s_lshl_b32 s30, s30, 10
    s_lshl_b32 s31, s28, 8
    s_add_u32 s30, s30, s31
    v_and_b32 v116, 0xf0, v2
    v_lshl_add_u32 v117, v125, 15, v116
    v_add_u32 v117, s30, v117
    s_lshl_b32 s30, s39, 6
    s_and_b32 s33, s3, 1
    s_lshl_b32 s33, s33, 5
    s_add_u32 s30, s30, s33
    s_and_b32 s33, s3, 6
    s_add_u32 s30, s30, s33
    s_lshl_b32 s30, s30, 10
    s_add_u32 s30, s30, s31
    v_lshl_add_u32 v118, v125, 13, v116
    v_add_u32 v118, s30, v118
    s_lshl_b32 s30, s39, 12
    s_lshl_b32 s31, s3, 6
    s_add_u32 s30, s30, s31
    s_add_u32 s30, s30, 0x40000
    v_lshlrev_b32 v113, 9, v126
    v_lshl_add_u32 v113, v125, 4, v113
    v_add_u32 v113, s30, v113
    v_lshlrev_b32 v114, 4, v126
    s_lshl_b32 s30, s26, 17
    s_lshl_b32 s31, s27, 7
    s_add_u32 s30, s30, s31
    s_lshl_b32 s31, s28, 15
    s_add_u32 s30, s30, s31
    s_add_u32 s30, s30, 0x100000
    v_lshl_add_u32 v115, v124, 12, v114
    v_add_u32 v115, s30, v115
    s_mul_i32 s30, s28, 1152
    v_mul_u32_u24 v119, 144, v124
    v_add3_u32 v119, v119, v114, s30
    v_bfe_u32 v120, v1, 1, 3
    v_mul_u32_u24 v120, 144, v120
    v_lshl_add_u32 v120, v125, 5, v120
    v_and_b32 v121, 16, v2
    v_add_u32 v120, v121, v120
    v_mov_b32 v33, 0
    s_movk_i32 s33, 0x2000
    v_mov_b32 v24, 0
    v_mov_b32 v25, 0
    v_mov_b32 v26, 0
    v_mov_b32 v27, 0
    v_mov_b32 v28, 0
    v_mov_b32 v29, 0
    v_mov_b32 v30, 0
    v_mov_b32 v31, 0
    s_cmp_lg_u32 s36, s26
    s_cbranch_scc1 L_nofpre
    s_lshr_b32 s30, s27, 2
    s_lshl_b32 s30, s30, 13
    s_and_b32 s31, s27, 3
    s_lshl_b32 s31, s31, 10
    s_add_u32 s30, s30, s31
    s_add_u32 s30, s30, 0x10000
    v_add_u32 v16, s30, v2
    global_load_dwordx4 v[12:15], v16, s[24:25] offset:0 sc1
L_nofpre:
    s_cmp_ge_u32 s39, 28
    s_barrier
    s_cbranch_scc1 L_now2
    global_load_dwordx4 v[4:7], v113, s[24:25] offset:0 sc1
    global_load_dwordx4 v[36:39], v118, s[18:19] nt
    global_load_dwordx4 v[40:43], v118, s[18:19] offset:1024 nt
L_now2:
    global_load_dwordx4 v[8:11], v115, s[24:25] offset:0 sc1
    global_load_dwordx4 v[52:55], v117, s[12:13] nt
    v_add_u32 v117, s33, v117
    global_load_dwordx4 v[56:59], v117, s[12:13] nt
    v_add_u32 v117, s33, v117
    global_load_dwordx4 v[60:63], v117, s[12:13] nt
    v_add_u32 v117, s33, v117
    global_load_dwordx4 v[64:67], v117, s[12:13] nt
    s_barrier
    ds_read_b128 v[16:19], v33 offset:10688
    s_waitcnt lgkmcnt(0)
    v_or3_b32 v22, v16, v17, v18
    v_or_b32 v22, v22, v19
    s_barrier
    s_cbranch_scc1 L_noffn
    s_waitcnt vmcnt(7)
    v_cmp_ne_u32 vcc, s29, v7
    s_cbranch_vccz L_pollh_done
    s_mov_b32 s35, 262144
L_pollh:
    global_load_dwordx4 v[4:7], v113, s[24:25] offset:0 sc1
L_pollh_chk:
    s_sub_u32 s35, s35, 1
    s_cbranch_scc1 L_pollh_done
    s_waitcnt vmcnt(0)
    v_cmp_ne_u32 vcc, s29, v7
    s_cbranch_vccnz L_pollh
L_pollh_done:
    v_add_f32_dpp v4, v4, v4 row_ror:4 row_mask:0xf bank_mask:0xf
    v_add_f32_dpp v5, v5, v5 row_ror:4 row_mask:0xf bank_mask:0xf
    s_nop 0
    v_add_f32_dpp v4, v4, v4 row_ror:2 row_mask:0xf bank_mask:0xf
    v_add_f32_dpp v5, v5, v5 row_ror:2 row_mask:0xf bank_mask:0xf
    s_nop 0
    v_add_f32_dpp v4, v4, v4 row_ror:1 row_mask:0xf bank_mask:0xf
    v_add_f32_dpp v5, v5, v5 row_ror:1 row_mask:0xf bank_mask:0xf
    v_cvt_pk_bf16_f32 v6, v4, v5
    v_lshlrev_b32 v4, 16, v6
    v_and_b32 v5, 0xffff0000, v6
    v_mul_f32 v6, 0xbfb8aa3b, v4
    v_mul_f32 v7, 0xbfb8aa3b, v5
    v_exp_f32 v6, v6
    v_exp_f32 v7, v7
    v_add_f32 v6, 1.0, v6
    v_add_f32 v7, 1.0, v7
    v_rcp_f32 v6, v6
    v_rcp_f32 v7, v7
    v_mul_f32 v4, v4, v6
    v_mul_f32 v5, v5, v7
    v_cvt_pk_bf16_f32 v6, v4, v5
    v_lshlrev_b32 v16, 16, v6
    v_and_b32 v17, 0xffff0000, v6
    s_waitcnt vmcnt(5)
    v_lshlrev_b32 v68, 16, v36
    v_and_b32 v69, 0xffff0000, v36
    v_lshlrev_b32 v70, 16, v37
    v_and_b32 v71, 0xffff0000, v37
    v_lshlrev_b32 v72, 16, v38
    v_and_b32 v73, 0xffff0000, v38
    v_lshlrev_b32 v74, 16, v39
    v_and_b32 v75, 0xffff0000, v39
    v_pk_fma_f32 v[24:25], v[68:69], v[16:17], v[24:25] op_sel_hi:[1,0,1]
    v_pk_fma_f32 v[26:27], v[70:71], v[16:17], v[26:27] op_sel_hi:[1,0,1]
    v_pk_fma_f32 v[28:29], v[72:73], v[16:17], v[28:29] op_sel_hi:[1,0,1]
    v_pk_fma_f32 v[30:31], v[74:75], v[16:17], v[30:31] op_sel_hi:[1,0,1]
    v_lshlrev_b32 v68, 16, v40
    v_and_b32 v69, 0xffff0000, v40
    v_lshlrev_b32 v70, 16, v41
    v_and_b32 v71, 0xffff0000, v41
    v_lshlrev_b32 v72, 16, v42
    v_and_b32 v73, 0xffff0000, v42
    v_lshlrev_b32 v74, 16, v43
    v_and_b32 v75, 0xffff0000, v43
    v_pk_fma_f32 v[24:25], v[68:69], v[16:17], v[24:25] op_sel:[0,1,0] op_sel_hi:[1,1,1]
    v_pk_fma_f32 v[26:27], v[70:71], v[16:17], v[26:27] op_sel:[0,1,0] op_sel_hi:[1,1,1]
    v_pk_fma_f32 v[28:29], v[72:73], v[16:17], v[28:29] op_sel:[0,1,0] op_sel_hi:[1,1,1]
    v_pk_fma_f32 v[30:31], v[74:75], v[16:17], v[30:31] op_sel:[0,1,0] op_sel_hi:[1,1,1]
L_noffn:
    v_readfirstlane_b32 s33, v22
    s_waitcnt vmcnt(0)
    s_mov_b32 s35, 262144
L_poll2:
    global_load_dwordx4 v[8:11], v115, s[24:25] offset:0 sc1
L_poll2_chk:
    s_sub_u32 s35, s35, 1
    s_cbranch_scc1 L_poll2_done
    s_waitcnt vmcnt(0)
    v_cmp_ne_u32 vcc, s29, v11
    s_cbranch_vccnz L_poll2
L_poll2_done:
    ds_write_b128 v119, v[8:11] offset:10752
    s_add_u32 s29, s29, 1
    s_cmp_lg_u32 s33, 0
    v_lshlrev_b32 v68, 16, v52
    v_and_b32 v69, 0xffff0000, v52
    v_lshlrev_b32 v70, 16, v53
    v_and_b32 v71, 0xffff0000, v53
    v_lshlrev_b32 v72, 16, v54
    v_and_b32 v73, 0xffff0000, v54
    v_lshlrev_b32 v74, 16, v55
    v_and_b32 v75, 0xffff0000, v55
    s_waitcnt lgkmcnt(0)
    s_barrier
    ds_read_b128 v[4:7], v120 offset:10752
    ds_read_b128 v[8:11], v120 offset:11904
    ds_read_b128 v[12:15], v120 offset:13056
    ds_read_b128 v[16:19], v120 offset:14208
    v_lshlrev_b32 v76, 16, v56
    v_and_b32 v77, 0xffff0000, v56
    v_lshlrev_b32 v78, 16, v57
    v_and_b32 v79, 0xffff0000, v57
    v_lshlrev_b32 v80, 16, v58
    v_and_b32 v81, 0xffff0000, v58
    v_lshlrev_b32 v82, 16, v59
    v_and_b32 v83, 0xffff0000, v59
    v_lshlrev_b32 v84, 16, v60
    v_and_b32 v85, 0xffff0000, v60
    v_lshlrev_b32 v86, 16, v61
    v_and_b32 v87, 0xffff0000, v61
    v_lshlrev_b32 v88, 16, v62
    v_and_b32 v89, 0xffff0000, v62
    v_lshlrev_b32 v90, 16, v63
    v_and_b32 v91, 0xffff0000, v63
    v_lshlrev_b32 v92, 16, v64
    v_and_b32 v93, 0xffff0000, v64
    v_lshlrev_b32 v94, 16, v65
    v_and_b32 v95, 0xffff0000, v65
    v_lshlrev_b32 v96, 16, v66
    v_and_b32 v97, 0xffff0000, v66
    v_lshlrev_b32 v98, 16, v67
    v_and_b32 v99, 0xffff0000, v67
    s_waitcnt lgkmcnt(0)
    v_max3_f32 v20, v6, v10, v14
    v_max_f32 v20, v20, v18
    s_nop 1
    v_max_f32_dpp v20, v20, v20 row_ror:8 row_mask:0xf bank_mask:0xf
    s_nop 1
    v_max_f32_dpp v20, v20, v20 row_ror:4 row_mask:0xf bank_mask:0xf
    s_nop 1
    v_max_f32_dpp v20, v20, v20 row_ror:2 row_mask:0xf bank_mask:0xf
    v_sub_f32 v6, v6, v20
    v_sub_f32 v10, v10, v20
    v_sub_f32 v14, v14, v20
    v_sub_f32 v18, v18, v20
    v_exp_f32 v6, v6
    v_exp_f32 v10, v10
    v_exp_f32 v14, v14
    v_exp_f32 v18, v18
    v_mul_f32 v4, v4, v6
    v_mul_f32 v5, v5, v6
    v_add_f32 v6, v6, v10
    v_fmac_f32 v4, v8, v10
    v_fmac_f32 v5, v9, v10
    v_add_f32 v21, v14, v18
    v_fmac_f32 v4, v12, v14
    v_fmac_f32 v5, v13, v14
    v_add_f32 v6, v6, v21
    v_fmac_f32 v4, v16, v18
    v_fmac_f32 v5, v17, v18
    v_add_f32_dpp v6, v6, v6 row_ror:8 row_mask:0xf bank_mask:0xf
    v_add_f32_dpp v4, v4, v4 row_ror:8 row_mask:0xf bank_mask:0xf
    v_add_f32_dpp v5, v5, v5 row_ror:8 row_mask:0xf bank_mask:0xf
    v_add_f32_dpp v6, v6, v6 row_ror:4 row_mask:0xf bank_mask:0xf
    v_add_f32_dpp v4, v4, v4 row_ror:4 row_mask:0xf bank_mask:0xf
    v_add_f32_dpp v5, v5, v5 row_ror:4 row_mask:0xf bank_mask:0xf
    v_add_f32_dpp v6, v6, v6 row_ror:2 row_mask:0xf bank_mask:0xf
    v_add_f32_dpp v4, v4, v4 row_ror:2 row_mask:0xf bank_mask:0xf
    v_add_f32_dpp v5, v5, v5 row_ror:2 row_mask:0xf bank_mask:0xf
    v_rcp_f32 v6, v6
    s_nop 0
    v_mul_f32 v4, v4, v6
    v_mul_f32 v5, v5, v6
    v_cvt_pk_bf16_f32 v22, v4, v5
    s_nop 1
    v_mov_b32_dpp v20, v22 quad_perm:[0,0,2,2] row_mask:0xf bank_mask:0xf
    v_mov_b32_dpp v21, v22 quad_perm:[1,1,3,3] row_mask:0xf bank_mask:0xf
    v_lshlrev_b32 v4, 16, v20
    v_and_b32 v5, 0xffff0000, v20
    v_lshlrev_b32 v6, 16, v21
    v_and_b32 v7, 0xffff0000, v21
    v_pk_fma_f32 v[24:25], v[68:69], v[4:5], v[24:25] op_sel_hi:[1,0,1]
    v_pk_fma_f32 v[26:27], v[70:71], v[4:5], v[26:27] op_sel_hi:[1,0,1]
    v_pk_fma_f32 v[28:29], v[72:73], v[4:5], v[28:29] op_sel_hi:[1,0,1]
    v_pk_fma_f32 v[30:31], v[74:75], v[4:5], v[30:31] op_sel_hi:[1,0,1]
    v_pk_fma_f32 v[24:25], v[76:77], v[4:5], v[24:25] op_sel:[0,1,0] op_sel_hi:[1,1,1]
    v_pk_fma_f32 v[26:27], v[78:79], v[4:5], v[26:27] op_sel:[0,1,0] op_sel_hi:[1,1,1]
    v_pk_fma_f32 v[28:29], v[80:81], v[4:5], v[28:29] op_sel:[0,1,0] op_sel_hi:[1,1,1]
    v_pk_fma_f32 v[30:31], v[82:83], v[4:5], v[30:31] op_sel:[0,1,0] op_sel_hi:[1,1,1]
    v_pk_fma_f32 v[24:25], v[84:85], v[6:7], v[24:25] op_sel_hi:[1,0,1]
    v_pk_fma_f32 v[26:27], v[86:87], v[6:7], v[26:27] op_sel_hi:[1,0,1]
    v_pk_fma_f32 v[28:29], v[88:89], v[6:7], v[28:29] op_sel_hi:[1,0,1]
    v_pk_fma_f32 v[30:31], v[90:91], v[6:7], v[30:31] op_sel_hi:[1,0,1]
    v_pk_fma_f32 v[24:25], v[92:93], v[6:7], v[24:25] op_sel:[0,1,0] op_sel_hi:[1,1,1]
    v_pk_fma_f32 v[26:27], v[94:95], v[6:7], v[26:27] op_sel:[0,1,0] op_sel_hi:[1,1,1]
    v_pk_fma_f32 v[28:29], v[96:97], v[6:7], v[28:29] op_sel:[0,1,0] op_sel_hi:[1,1,1]
    v_pk_fma_f32 v[30:31], v[98:99], v[6:7], v[30:31] op_sel:[0,1,0] op_sel_hi:[1,1,1]
    s_nop 0
    v_permlane32_swap_b32 v24, v28
    v_permlane32_swap_b32 v25, v29
    v_permlane32_swap_b32 v26, v30
    v_permlane32_swap_b32 v27, v31
    v_add_f32 v24, v24, v28
    v_add_f32 v25, v25, v29
    v_add_f32 v26, v26, v30
    v_add_f32 v27, v27, v31
    s_nop 0
    v_permlane16_swap_b32 v24, v26
    v_permlane16_swap_b32 v25, v27
    v_add_f32 v24, v24, v26
    v_add_f32 v25, v25, v27
    v_mov_b32 v27, s29
    s_cbranch_scc1 L_out_remote
    global_store_dwordx4 v115, v[24:27], s[24:25]
    s_endpgm
L_out_remote:
    global_store_dwordx4 v115, v[24:27], s[24:25] sc1
    s_endpgm
L_att_k:
    s_load_dword s29, s[24:25], 0x0
    s_waitcnt vmcnt(4)
    global_load_dwordx4 v[16:19], v3, s[58:59] nt
    v_add_u32 v3, s32, v3
    s_waitcnt vmcnt(4)
    global_load_dwordx4 v[20:23], v3, s[58:59] nt
    v_add_u32 v3, s32, v3
    s_waitcnt vmcnt(4)
    global_load_dwordx4 v[24:27], v3, s[58:59] nt
    v_add_u32 v3, s32, v3
    s_waitcnt vmcnt(4)
    global_load_dwordx4 v[28:31], v3, s[58:59] nt
    v_add_u32 v3, s32, v3
    s_waitcnt vmcnt(4)
    global_load_dwordx4 v[32:35], v3, s[58:59] nt
L_att:
    v_add_u32 v3, s30, v2
    s_lshl_b32 s30, s26, 14
    s_lshl_b32 s31, s36, 12
    s_add_u32 s30, s30, s31
    s_add_u32 s30, s30, 0x20000
    v_and_b32 v120, 0x1f0, v2
    v_lshrrev_b32 v121, 5, v1
    v_lshl_add_u32 v120, v121, 11, v120
    v_add_u32 v120, s30, v120
    v_bfe_u32 v118, v1, 3, 2
    v_lshlrev_b32 v119, 4, v126
    v_lshl_add_u32 v119, v118, 2, v119
    v_lshl_add_u32 v119, v121, 7, v119
    s_lshl_b32 s30, s36, 8
    v_add_u32 v119, s30, v119
    s_lshl_b32 s30, s26, 5
    s_add_u32 s30, s30, s27
    s_lshl_b32 s30, s30, 12
    s_lshl_b32 s31, s36, 10
    s_add_u32 s30, s30, s31
    s_add_u32 s30, s30, 0x100000
    v_add_u32 v0, s30, v2
    s_mov_b32 s37, 0x05040100
    s_mov_b32 s38, 0x07060302
    s_mov_b32 s39, 0x3fb8aa3b
    s_getreg_b32 s34, hwreg(HW_REG_XCC_ID)
    s_lshl_b32 s31, s36, 11
    s_add_u32 s31, s31, 2048
    v_and_b32 v121, 15, v1
    v_lshlrev_b32 v121, 2, v121
    v_lshl_add_u32 v121, v125, 9, v121
    v_add_u32 v121, s31, v121
    s_lshl_b32 s30, s36, 2
    v_lshlrev_b32 v117, 4, v123
    v_add_u32 v118, s30, v117
    v_lshl_add_u32 v122, v125, 4, s30
    s_lshl_b32 s31, s36, 9
    v_lshl_add_u32 v123, v1, 3, s31
    v_mov_b32 v1, v117
    s_waitcnt vmcnt(5)
    global_load_dwordx4 v[36:39], v3, s[8:9] nt
    v_add_u32 v3, s32, v3
    s_waitcnt vmcnt(5)
    global_load_dwordx4 v[40:43], v3, s[8:9] nt
    v_add_u32 v3, s32, v3
    s_waitcnt vmcnt(5)
    global_load_dwordx4 v[44:47], v3, s[8:9] nt
    v_add_u32 v3, s32, v3
    global_load_dwordx4 v[100:103], v120, s[24:25] offset:0 sc1
    global_load_dwordx4 v[104:107], v120, s[24:25] offset:512 sc1
    global_load_dwordx4 v[108:111], v120, s[24:25] offset:1024 sc1
    global_load_dwordx4 v[112:115], v120, s[24:25] offset:1536 sc1
    s_waitcnt vmcnt(9)
    global_load_dwordx4 v[48:51], v3, s[8:9] nt
    v_add_u32 v3, s32, v3
    s_waitcnt vmcnt(9)
    global_load_dwordx4 v[52:55], v3, s[8:9] nt
    v_add_u32 v3, s32, v3
    s_waitcnt vmcnt(9)
    global_load_dwordx4 v[56:59], v3, s[8:9] nt
    v_add_u32 v3, s32, v3
    s_waitcnt lgkmcnt(0)
    s_add_u32 s29, s29, 1
    s_waitcnt vmcnt(3)
    v_cmp_ne_u32 s[40:41], s29, v103
    v_cmp_ne_u32 s[42:43], s29, v107
    v_cmp_ne_u32 s[44:45], s29, v111
    v_cmp_ne_u32 s[46:47], s29, v115
    s_or_b64 s[56:57], s[40:41], s[42:43]
    s_or_b64 s[56:57], s[56:57], s[44:45]
    s_or_b64 s[56:57], s[56:57], s[46:47]
    s_cbranch_scc0 L_q1ok
    global_load_dwordx4 v[100:103], v120, s[24:25] offset:0 sc1
    global_load_dwordx4 v[104:107], v120, s[24:25] offset:512 sc1
    global_load_dwordx4 v[108:111], v120, s[24:25] offset:1024 sc1
    global_load_dwordx4 v[112:115], v120, s[24:25] offset:1536 sc1
L_q1ok:
    global_load_dwordx4 v[60:63], v3, s[8:9] nt
    v_add_u32 v3, s32, v3
    global_load_dwordx4 v[64:67], v3, s[8:9] nt
    s_cbranch_scc0 L_pollq_done
    s_waitcnt vmcnt(2)
    v_cmp_ne_u32 s[40:41], s29, v103
    v_cmp_ne_u32 s[42:43], s29, v107
    v_cmp_ne_u32 s[44:45], s29, v111
    v_cmp_ne_u32 s[46:47], s29, v115
    s_or_b64 s[56:57], s[40:41], s[42:43]
    s_or_b64 s[56:57], s[56:57], s[44:45]
    s_or_b64 s[56:57], s[56:57], s[46:47]
    s_cbranch_scc0 L_pollq_done
    s_mov_b32 s35, 262144
L_pollq:
    s_cmp_lt_u32 s35, 262138
    s_cselect_b32 s31, 0x80000, 0
    v_xor_b32 v120, s31, v120
    global_load_dwordx4 v[100:103], v120, s[24:25] offset:0 sc1
    global_load_dwordx4 v[104:107], v120, s[24:25] offset:512 sc1
    global_load_dwordx4 v[108:111], v120, s[24:25] offset:1024 sc1
    global_load_dwordx4 v[112:115], v120, s[24:25] offset:1536 sc1
L_pollq_chk:
    s_sub_u32 s35, s35, 1
    s_cbranch_scc1 L_pollq_done
    s_waitcnt vmcnt(0)
    v_cmp_ne_u32 s[40:41], s29, v103
    v_cmp_ne_u32 s[42:43], s29, v107
    v_cmp_ne_u32 s[44:45], s29, v111
    v_cmp_ne_u32 s[46:47], s29, v115
    s_or_b64 s[56:57], s[40:41], s[42:43]
    s_or_b64 s[56:57], s[56:57], s[44:45]
    s_or_b64 s[56:57], s[56:57], s[46:47]
    s_cbranch_scc1 L_pollq
L_pollq_done:
    v_add_f32 v100, v100, v104
    v_add_f32 v101, v101, v105
    v_add_f32 v108, v108, v112
    v_add_f32 v109, v109, v113
    v_add_f32 v100, v100, v108
    v_add_f32 v101, v101, v109
    v_cvt_pk_bf16_f32 v100, v100, v101
    ds_write_b32 v119, v100 offset:1024
    v_xor_b32 v116, s34, v102
    v_xor_b32 v117, s34, v106
    v_xor_b32 v119, s34, v110
    v_xor_b32 v120, s34, v114
    s_waitcnt lgkmcnt(0)
    s_barrier
    ds_read_b128 v[100:103], v127 offset:1024
    v_or3_b32 v116, v116, v117, v119
    v_or_b32 v116, v116, v120
    v_cmp_ne_u32 vcc, 0, v116
    s_or_b32 s31, vcc_lo, vcc_hi
    v_mov_b32 v116, s30
    v_mov_b32 v117, s31
    s_lshl_b32 s31, s36, 4
    v_mov_b32 v120, s31
    v_mov_b32 v119, 0
    s_waitcnt lgkmcnt(0)
    v_mfma_f32_16x16x32_bf16 v[112:115], v[4:7], v[100:103], 0
    v_mfma_f32_16x16x32_bf16 v[4:7], v[8:11], v[100:103], 0
    v_mfma_f32_16x16x32_bf16 v[8:11], v[12:15], v[100:103], 0
    v_mfma_f32_16x16x32_bf16 v[12:15], v[16:19], v[100:103], 0
    v_mfma_f32_16x16x32_bf16 v[16:19], v[20:23], v[100:103], 0
    v_mfma_f32_16x16x32_bf16 v[20:23], v[24:27], v[100:103], 0
    v_mfma_f32_16x16x32_bf16 v[24:27], v[28:31], v[100:103], 0
    v_mfma_f32_16x16x32_bf16 v[28:31], v[32:35], v[100:103], 0
    ds_write_b32 v116, v117 offset:10688
    v_mov_b32_dpp v104, v112 quad_perm:[0,0,0,0] row_mask:0xf bank_mask:0xf
    v_mov_b32_dpp v105, v4 quad_perm:[0,0,0,0] row_mask:0xf bank_mask:0xf
    v_mov_b32_dpp v106, v8 quad_perm:[0,0,0,0] row_mask:0xf bank_mask:0xf
    v_mov_b32_dpp v107, v12 quad_perm:[0,0,0,0] row_mask:0xf bank_mask:0xf
    v_mov_b32_dpp v108, v16 quad_perm:[0,0,0,0] row_mask:0xf bank_mask:0xf
    v_mov_b32_dpp v109, v20 quad_perm:[0,0,0,0] row_mask:0xf bank_mask:0xf
    v_mov_b32_dpp v110, v24 quad_perm:[0,0,0,0] row_mask:0xf bank_mask:0xf
    v_mov_b32_dpp v111, v28 quad_perm:[0,0,0,0] row_mask:0xf bank_mask:0xf
    v_add_f32_dpp v104, v113, v104 quad_perm:[1,1,1,1] row_mask:0xf bank_mask:0xf
    v_add_f32_dpp v105, v5, v105 quad_perm:[1,1,1,1] row_mask:0xf bank_mask:0xf
    v_add_f32_dpp v106, v9, v106 quad_perm:[1,1,1,1] row_mask:0xf bank_mask:0xf
    v_add_f32_dpp v107, v13, v107 quad_perm:[1,1,1,1] row_mask:0xf bank_mask:0xf
    v_add_f32_dpp v108, v17, v108 quad_perm:[1,1,1,1] row_mask:0xf bank_mask:0xf
    v_add_f32_dpp v109, v21, v109 quad_perm:[1,1,1,1] row_mask:0xf bank_mask:0xf
    v_add_f32_dpp v110, v25, v110 quad_perm:[1,1,1,1] row_mask:0xf bank_mask:0xf
    v_add_f32_dpp v111, v29, v111 quad_perm:[1,1,1,1] row_mask:0xf bank_mask:0xf
    v_add_f32_dpp v104, v114, v104 quad_perm:[2,2,2,2] row_mask:0xf bank_mask:0xf
    v_add_f32_dpp v105, v6, v105 quad_perm:[2,2,2,2] row_mask:0xf bank_mask:0xf
    v_add_f32_dpp v106, v10, v106 quad_perm:[2,2,2,2] row_mask:0xf bank_mask:0xf
    v_add_f32_dpp v107, v14, v107 quad_perm:[2,2,2,2] row_mask:0xf bank_mask:0xf
    v_add_f32_dpp v108, v18, v108 quad_perm:[2,2,2,2] row_mask:0xf bank_mask:0xf
    v_add_f32_dpp v109, v22, v109 quad_perm:[2,2,2,2] row_mask:0xf bank_mask:0xf
    v_add_f32_dpp v110, v26, v110 quad_perm:[2,2,2,2] row_mask:0xf bank_mask:0xf
    v_add_f32_dpp v111, v30, v111 quad_perm:[2,2,2,2] row_mask:0xf bank_mask:0xf
    v_add_f32_dpp v104, v115, v104 quad_perm:[3,3,3,3] row_mask:0xf bank_mask:0xf
    v_add_f32_dpp v105, v7, v105 quad_perm:[3,3,3,3] row_mask:0xf bank_mask:0xf
    v_add_f32_dpp v106, v11, v106 quad_perm:[3,3,3,3] row_mask:0xf bank_mask:0xf
    v_add_f32_dpp v107, v15, v107 quad_perm:[3,3,3,3] row_mask:0xf bank_mask:0xf
    v_add_f32_dpp v108, v19, v108 quad_perm:[3,3,3,3] row_mask:0xf bank_mask:0xf
    v_add_f32_dpp v109, v23, v109 quad_perm:[3,3,3,3] row_mask:0xf bank_mask:0xf
    v_add_f32_dpp v110, v27, v110 quad_perm:[3,3,3,3] row_mask:0xf bank_mask:0xf
    v_add_f32_dpp v111, v31, v111 quad_perm:[3,3,3,3] row_mask:0xf bank_mask:0xf
    v_cvt_pk_bf16_f32 v112, v104, v105
    v_cvt_pk_bf16_f32 v113, v106, v107
    v_cvt_pk_bf16_f32 v114, v108, v109
    v_cvt_pk_bf16_f32 v115, v110, v111
    v_lshlrev_b32 v104, 16, v112
    v_and_b32 v105, 0xffff0000, v112
    v_lshlrev_b32 v106, 16, v113
    v_and_b32 v107, 0xffff0000, v113
    v_lshlrev_b32 v108, 16, v114
    v_and_b32 v109, 0xffff0000, v114
    v_lshlrev_b32 v110, 16, v115
    v_and_b32 v111, 0xffff0000, v115
    v_mul_f32 v104, 0x3db504f3, v104
    v_mul_f32 v105, 0x3db504f3, v105
    v_mul_f32 v106, 0x3db504f3, v106
    v_mul_f32 v107, 0x3db504f3, v107
    v_mul_f32 v108, 0x3db504f3, v108
    v_mul_f32 v109, 0x3db504f3, v109
    v_mul_f32 v110, 0x3db504f3, v110
    v_mul_f32 v111, 0x3db504f3, v111
    v_cvt_pk_bf16_f32 v112, v104, v105
    v_cvt_pk_bf16_f32 v113, v106, v107
    v_cvt_pk_bf16_f32 v114, v108, v109
    v_cvt_pk_bf16_f32 v115, v110, v111
    v_lshlrev_b32 v104, 16, v112
    v_and_b32 v105, 0xffff0000, v112
    v_lshlrev_b32 v106, 16, v113
    v_and_b32 v107, 0xffff0000, v113
    v_lshlrev_b32 v108, 16, v114
    v_and_b32 v109, 0xffff0000, v114
    v_lshlrev_b32 v110, 16, v115
    v_and_b32 v111, 0xffff0000, v115
    v_max3_f32 v116, v104, v105, v106
    v_max3_f32 v117, v107, v108, v109
    v_max3_f32 v116, v116, v110, v111
    v_max_f32 v116, v116, v117
    v_mov_b32 v117, v116
    v_mov_b32 v8, 0x3f803f80
    v_mov_b32 v9, 0x3f803f80
    v_permlane16_swap_b32 v116, v117
    v_max_f32 v116, v116, v117
    v_mov_b32 v117, v116
    v_mov_b32 v10, 0x3f803f80
    v_mov_b32 v11, 0x3f803f80
    v_permlane32_swap_b32 v116, v117
    v_max_f32 v116, v116, v117
    ds_write_b32 v118, v116 offset:10240
    v_perm_b32 v68, v40, v36, s37
    v_perm_b32 v72, v40, v36, s38
    v_perm_b32 v76, v41, v37, s37
    v_perm_b32 v80, v41, v37, s38
    v_perm_b32 v84, v42, v38, s37
    v_perm_b32 v88, v42, v38, s38
    v_perm_b32 v92, v43, v39, s37
    v_perm_b32 v96, v43, v39, s38
    s_waitcnt lgkmcnt(0)
    s_barrier
    ds_read_b128 v[100:103], v1 offset:10240
    ds_read_b128 v[4:7], v120 offset:10240
    ds_read_b128 v[12:15], v119 offset:10688
    v_mov_b32 v19, s29
    s_waitcnt lgkmcnt(2)
    v_max3_f32 v116, v100, v101, v102
    v_max_f32 v116, v116, v103
    v_mul_f32 v116, s39, v116
    v_fma_f32 v104, v104, s39, -v116
    v_fma_f32 v105, v105, s39, -v116
    v_fma_f32 v106, v106, s39, -v116
    v_fma_f32 v107, v107, s39, -v116
    v_fma_f32 v108, v108, s39, -v116
    v_fma_f32 v109, v109, s39, -v116
    v_fma_f32 v110, v110, s39, -v116
    v_fma_f32 v111, v111, s39, -v116
    v_exp_f32 v104, v104
    v_exp_f32 v105, v105
    v_exp_f32 v106, v106
    v_exp_f32 v107, v107
    v_exp_f32 v108, v108
    v_exp_f32 v109, v109
    v_exp_f32 v110, v110
    v_exp_f32 v111, v111
    s_waitcnt lgkmcnt(0)
    v_max3_f32 v117, v4, v5, v6
    v_max_f32 v117, v117, v7
    v_cvt_pk_bf16_f32 v112, v104, v105
    v_cvt_pk_bf16_f32 v113, v106, v107
    v_cvt_pk_bf16_f32 v114, v108, v109
    v_cvt_pk_bf16_f32 v115, v110, v111
    v_mul_f32 v117, s39, v117
    v_or3_b32 v12, v12, v13, v14
    v_mfma_f32_16x16x32_bf16 v[100:103], v[112:115], v[8:11], 0
    v_or_b32 v12, v12, v15
    v_cmp_ne_u32 vcc, 0, v12
    s_waitcnt vmcnt(4)
    v_perm_b32 v69, v48, v44, s37
    v_perm_b32 v73, v48, v44, s38
    v_perm_b32 v77, v49, v45, s37
    v_perm_b32 v81, v49, v45, s38
    v_perm_b32 v85, v50, v46, s37
    v_perm_b32 v89, v50, v46, s38
    v_perm_b32 v93, v51, v47, s37
    v_perm_b32 v97, v51, v47, s38
    ds_write_b32 v122, v100 offset:10304
    s_waitcnt vmcnt(2)
    v_perm_b32 v70, v56, v52, s37
    v_perm_b32 v74, v56, v52, s38
    v_perm_b32 v78, v57, v53, s37
    v_perm_b32 v82, v57, v53, s38
    v_perm_b32 v86, v58, v54, s37
    v_perm_b32 v90, v58, v54, s38
    v_perm_b32 v94, v59, v55, s37
    v_perm_b32 v98, v59, v55, s38
    s_waitcnt vmcnt(0)
    v_perm_b32 v71, v64, v60, s37
    v_perm_b32 v75, v64, v60, s38
    v_perm_b32 v79, v65, v61, s37
    v_perm_b32 v83, v65, v61, s38
    v_perm_b32 v87, v66, v62, s37
    v_perm_b32 v91, v66, v62, s38
    v_perm_b32 v95, v67, v63, s37
    v_perm_b32 v99, v67, v63, s38
    v_mfma_f32_16x16x32_bf16 v[36:39], v[112:115], v[68:71], 0
    v_mfma_f32_16x16x32_bf16 v[40:43], v[112:115], v[72:75], 0
    v_mfma_f32_16x16x32_bf16 v[44:47], v[112:115], v[76:79], 0
    v_mfma_f32_16x16x32_bf16 v[48:51], v[112:115], v[80:83], 0
    v_mfma_f32_16x16x32_bf16 v[52:55], v[112:115], v[84:87], 0
    v_mfma_f32_16x16x32_bf16 v[56:59], v[112:115], v[88:91], 0
    v_mfma_f32_16x16x32_bf16 v[60:63], v[112:115], v[92:95], 0
    v_mfma_f32_16x16x32_bf16 v[64:67], v[112:115], v[96:99], 0
    s_nop 1
    ds_write2_b32 v121, v36, v40 offset0:0 offset1:16
    s_nop 0
    ds_write2_b32 v121, v44, v48 offset0:32 offset1:48
    s_nop 0
    ds_write2_b32 v121, v52, v56 offset0:64 offset1:80
    s_nop 0
    ds_write2_b32 v121, v60, v64 offset0:96 offset1:112
    s_waitcnt lgkmcnt(0)
    s_barrier
    ds_read_b128 v[4:7], v120 offset:10304
    ds_read_b64 v[20:21], v123 offset:2048
    ds_read_b64 v[22:23], v123 offset:4096
    ds_read_b64 v[24:25], v123 offset:6144
    ds_read_b64 v[26:27], v123 offset:8192
    s_waitcnt lgkmcnt(4)
    v_add_f32 v4, v4, v5
    v_add_f32 v6, v6, v7
    v_add_f32 v4, v4, v6
    v_rcp_f32 v5, v4
    v_log_f32 v18, v4
    s_waitcnt lgkmcnt(2)
    v_add_f32 v20, v20, v22
    v_add_f32 v21, v21, v23
    v_add_f32 v18, v18, v117
    s_waitcnt lgkmcnt(0)
    v_add_f32 v24, v24, v26
    v_add_f32 v25, v25, v27
    v_add_f32 v20, v20, v24
    v_add_f32 v21, v21, v25
    v_mul_f32 v16, v20, v5
    v_mul_f32 v17, v21, v5
    s_cbranch_vccnz L_o_remote
    global_store_dwordx4 v0, v[16:19], s[24:25]
    s_branch L_o_done
L_o_remote:
    global_store_dwordx4 v0, v[16:19], s[24:25] sc1
L_o_done:
    s_and_b32 s32, s27, 7
    s_cmp_eq_u32 s32, s26
    s_cselect_b32 s30, 1, 0
    s_cmp_gt_u32 s36, s30
    s_cbranch_scc1 L_fin
    s_add_u32 s29, s29, 1
    s_lshr_b32 s33, s27, 2
    s_lshl_b32 s33, s33, 13
    s_and_b32 s31, s27, 3
    s_lshl_b32 s31, s31, 10
    s_add_u32 s33, s33, s31
    s_add_u32 s33, s33, 0x10000
    s_cmp_lg_u32 s36, 0
    s_cbranch_scc1 L_stageb
    s_lshl_b32 s31, s26, 7
    s_add_u32 s30, s33, s31
    v_lshl_add_u32 v37, v126, 4, s30
    s_barrier
    s_mov_b32 s35, 262144
L_poll3:
    global_load_dwordx4 v[4:7], v0, s[24:25] offset:0 sc1
    global_load_dwordx4 v[8:11], v0, s[24:25] offset:1024 sc1
    global_load_dwordx4 v[12:15], v0, s[24:25] offset:2048 sc1
    global_load_dwordx4 v[16:19], v0, s[24:25] offset:3072 sc1
L_poll3_chk:
    s_sub_u32 s35, s35, 1
    s_cbranch_scc1 L_poll3_done
    s_waitcnt vmcnt(0)
    v_cmp_ne_u32 s[40:41], s29, v7
    v_cmp_ne_u32 s[42:43], s29, v11
    v_cmp_ne_u32 s[44:45], s29, v15
    v_cmp_ne_u32 s[46:47], s29, v19
    s_or_b64 s[56:57], s[40:41], s[42:43]
    s_or_b64 s[56:57], s[56:57], s[44:45]
    s_or_b64 s[56:57], s[56:57], s[46:47]
    s_cbranch_scc1 L_poll3
L_poll3_done:
    v_add_f32 v24, v4, v8
    v_add_f32 v25, v5, v9
    v_add_f32 v28, v12, v16
    v_add_f32 v29, v13, v17
    v_add_f32 v24, v24, v28
    v_add_f32 v25, v25, v29
    v_mov_b32 v27, s29
    s_nop 0
    v_permlane32_swap_b32 v24, v25
    v_add_f32 v24, v24, v25
    v_mov_b32 v25, v24
    s_nop 1
    v_permlane16_swap_b32 v24, v25
    v_add_f32 v24, v24, v25
    s_nop 1
    v_add_f32_dpp v24, v24, v24 row_ror:8 row_mask:0xf bank_mask:0xf
    v_mov_b32 v25, v24
    s_nop 1
    v_permlane32_swap_b32 v24, v25
    s_mov_b64 exec, 0xff
    global_store_dwordx4 v37, v[24:27], s[24:25] sc1
    s_endpgm
L_stageb:
    s_lshr_b32 s30, s27, 3
    s_lshl_b32 s30, s30, 8
    s_and_b32 s31, s27, 1
    s_lshl_b32 s31, s31, 7
    s_add_u32 s30, s30, s31
    s_and_b32 s31, s27, 6
    s_lshl_b32 s31, s31, 1
    s_add_u32 s30, s30, s31
    v_lshl_add_u32 v38, v126, 4, s30
    global_load_dword v39, v38, s[4:5]
    v_add_u32 v36, s33, v2
    s_barrier
    s_waitcnt vmcnt(0)
    v_lshlrev_b32 v34, 16, v39
    v_and_b32 v35, 0xffff0000, v39
    s_barrier
    s_mov_b32 s35, 262144
L_poll4:
    global_load_dwordx4 v[20:23], v36, s[24:25] offset:0 sc1
L_poll4_chk:
    s_sub_u32 s35, s35, 1
    s_cbranch_scc1 L_poll4_done
    s_waitcnt vmcnt(0)
    v_cmp_ne_u32 vcc, s29, v23
    s_cbranch_vccnz L_poll4
L_poll4_done:
    v_permlane32_swap_b32 v20, v21
    v_add_f32 v20, v20, v21
    v_mov_b32 v21, v20
    s_nop 1
    v_permlane16_swap_b32 v20, v21
    v_add_f32 v20, v20, v21
    s_nop 1
    v_add_f32_dpp v20, v20, v20 row_ror:8 row_mask:0xf bank_mask:0xf
    v_mov_b32 v21, v20
    s_nop 1
    v_permlane32_swap_b32 v20, v21
    v_add_f32 v20, v20, v34
    v_add_f32 v21, v21, v35
    v_cvt_pk_bf16_f32 v20, v20, v21
    s_mov_b64 exec, 0xff
    global_store_dword v38, v20, s[20:21]
    s_cmp_lg_u32 s27, 0
    s_cbranch_scc1 L_fin
    global_store_dword v119, v23, s[24:25] offset:0
L_fin:
L_end:
    s_endpgm
L_code_end:
.fill 256, 4, 0xbf800000
.section .rodata,"a"
.p2align 6
.amdhsa_kernel parallel_sum__sliding_block_cached__dense_activation_silu__decode_kernel
  .amdhsa_next_free_vgpr 128
  .amdhsa_next_free_sgpr 64
  .amdhsa_accum_offset 128
  .amdhsa_group_segment_fixed_size 0
  .amdhsa_kernarg_size 88
  .amdhsa_user_sgpr_count 2
  .amdhsa_user_sgpr_kernarg_segment_ptr 1
  .amdhsa_system_sgpr_workgroup_id_x 1
.end_amdhsa_kernel
```
